```python
import torch

def _softmax(x, axis=-1):
    return torch.softmax(x, dim=axis)
def _gelu(x):
    return torch.nn.functional.gelu(x, approximate="tanh")
def _silu(x):
    return torch.nn.functional.silu(x)
def _sigmoid(x):
    return torch.sigmoid(x)
def _layernorm(x, axis=-1, eps=1e-5):
    m = x.mean(dim=axis, keepdim=True)
    v = x.var(dim=axis, keepdim=True, unbiased=False)
    return (x - m) / torch.sqrt(v + eps)
def _scatter_add(tgt, idx, src, axis=0):
    return tgt.clone().index_add_(axis, idx, src)
def _segment_sum(src, seg, n):
    out = torch.zeros((n,) + src.shape[1:], dtype=src.dtype)
    return out.index_add_(0, seg, src)
def _pad(x, pw):
    flat = tuple(v for pair in reversed(pw) for v in pair)
    return torch.nn.functional.pad(x, flat)

kernel_name = 'standalone__spectral_fnet__prompt'

def setup_inputs():

    _w = (lambda a: (lambda t: t.to(torch.bfloat16) if t.is_floating_point() else t)(torch.as_tensor(a)))
    B, S, D = 1, 2048, 512
    ns = torch.arange(S)[:, None] * torch.arange(S)[None, :]
    nd = torch.arange(D)[:, None] * torch.arange(D)[None, :]
    Ws_re = torch.cos(-2.0 * torch.pi * ns / S).to(float)
    Ws_im = torch.sin(-2.0 * torch.pi * ns / S).to(float)
    Wd_re = torch.cos(-2.0 * torch.pi * nd / D).to(float)
    Wd_im = torch.sin(-2.0 * torch.pi * nd / D).to(float)
    return {
        "x": _w((lambda *s: torch.randn(*s, dtype=torch.bfloat16) * 0.05)(B, S, D)),
        "dft_seq_re": _w(Ws_re),
        "dft_seq_im": _w(Ws_im),
        "dft_hid_re": _w(Wd_re),
        "dft_hid_im": _w(Wd_im),
    }

def reference(x, dft_seq_re, dft_seq_im, dft_hid_re, dft_hid_im):
    a = torch.einsum("bsd,ed->bse", x, dft_hid_re)
    b = torch.einsum("bsd,ed->bse", x, dft_hid_im)
    y = torch.einsum("ts,bse->bte", dft_seq_re, a) - torch.einsum("ts,bse->bte", dft_seq_im, b)
    return y
```

```asm
; @launch grid=(257,1,1) block=(256,1,1) lds=29696
.amdgcn_target "amdgcn-amd-amdhsa--gfx950"
.text
.globl standalone__spectral_fnet__prompt_kernel
.p2align 8
.type standalone__spectral_fnet__prompt_kernel,@function
standalone__spectral_fnet__prompt_kernel:
    s_cmpk_gt_u32 s2, 256
    s_cbranch_scc1 L_end
    s_load_dwordx2 s[8:9], s[0:1], 0
    s_load_dwordx2 s[12:13], s[0:1], 56
    s_load_dwordx2 s[32:33], s[0:1], 40
    s_bfe_u32 s17, s2, 0x30003
    s_sub_u32 s18, 16, s17
    s_cmp_eq_u32 s17, 0
    s_cselect_b32 s18, 8, s18
    s_bitcmp1_b32 s2, 2
    s_cselect_b32 s18, s18, s17
    s_and_b32 s17, s2, 3
    s_lshr_b32 s20, s2, 6
    s_lshl2_add_u32 s17, s17, s20
    v_lshrrev_b32 v3, 2, v0
    v_lshl_add_u32 v6, v3, 4, s18
    v_and_b32 v7, 3, v0
    v_lshl_add_u32 v7, s17, 2, v7
    v_lshlrev_b32 v8, 3, v7
    v_lshl_add_u32 v92, v6, 10, v8
    v_max_u32 v8, 4, v8
    v_lshl_add_u32 v93, v6, 10, v8
    v_sub_u32 v93, 1016, v93
    v_bfe_u32 v93, v93, 0, 21
    s_bfm_b32 s19, 1, 20
    v_xor_b32 v94, s19, v93
    s_lshl_b32 s10, s19, 1
    s_lshr_b32 s11, s19, 3
    s_lshl_b32 s14, s19, 4
    s_mov_b32 s15, s11
    s_waitcnt lgkmcnt(0)
    buffer_load_dword v15, off, s[12:15], 0
    buffer_load_dwordx2 v[64:65], v92, s[8:11], 0 offen
    buffer_load_dwordx3 v[68:70], v93, s[8:11], 0 offen
    buffer_load_dwordx2 v[66:67], v92, s[8:11], s19 offen
    buffer_load_dwordx3 v[72:74], v94, s[8:11], 0 offen
    v_cmp_eq_u32 s[30:31], 0, v7
    v_lshrrev_b32 v1, 6, v0
    v_and_b32 v2, 63, v0
    v_readfirstlane_b32 s16, v1
    v_and_b32 v4, 15, v2
    v_lshrrev_b32 v5, 4, v2
    s_mov_b32 s37, 0x00010001
    v_lshl_add_u32 v6, v4, 2, s16
    v_cvt_f32_u32 v7, v6
    v_cvt_f32_u32 v8, v5
    v_mul_f32 v7, 0x3c000000, v7
    v_mul_f32 v8, 4.0, v8
    v_mul_f32 v12, v7, v8
    v_mul_f32 v8, 0x41500000, v7
    v_cmp_eq_u32 vcc, 0, v6
    v_mov_b32 v9, 0xbf803f80
    v_cos_f32 v48, v12
    v_sin_f32 v50, v12
    v_add_f32 v12, v12, v7
    v_cos_f32 v49, v12
    v_sin_f32 v51, v12
    v_add_f32 v12, v12, v7
    v_cvt_pk_bf16_f32 v16, v48, v49
    v_cvt_pk_bf16_f32 v20, v50, v51
    v_cndmask_b32 v20, v20, v9, vcc
    v_cos_f32 v48, v12
    v_sin_f32 v50, v12
    v_add_f32 v12, v12, v7
    v_cos_f32 v49, v12
    v_sin_f32 v51, v12
    v_add_f32 v12, v12, v8
    v_cvt_pk_bf16_f32 v17, v48, v49
    v_cvt_pk_bf16_f32 v21, v50, v51
    v_cndmask_b32 v21, v21, v9, vcc
    v_cos_f32 v48, v12
    v_sin_f32 v50, v12
    v_add_f32 v12, v12, v7
    v_cos_f32 v49, v12
    v_sin_f32 v51, v12
    v_add_f32 v12, v12, v7
    v_cvt_pk_bf16_f32 v18, v48, v49
    v_cvt_pk_bf16_f32 v22, v50, v51
    v_cndmask_b32 v22, v22, v9, vcc
    v_cos_f32 v48, v12
    v_sin_f32 v50, v12
    v_add_f32 v12, v12, v7
    v_cos_f32 v49, v12
    v_sin_f32 v51, v12
    s_mov_b32 s22, 0x80008000
    v_cvt_pk_bf16_f32 v19, v48, v49
    v_cvt_pk_bf16_f32 v23, v50, v51
    v_cndmask_b32 v23, v23, v9, vcc
    s_bitcmp1_b32 s16, 1
    s_cselect_b32 s24, s22, 0
    s_bitcmp1_b32 s16, 0
    s_cbranch_scc1 L_odd
    v_xor_b32 v24, s24, v16
    v_xor_b32 v25, s24, v17
    v_xor_b32 v26, s24, v18
    v_xor_b32 v27, s24, v19
    v_xor_b32 v28, s24, v20
    v_xor_b32 v29, s24, v21
    v_xor_b32 v30, s24, v22
    v_xor_b32 v31, s24, v23
    s_mov_b32 s23, 0
    s_branch L_tab
L_odd:
    s_xor_b32 s25, s22, s24
    s_mov_b32 s23, s22
    v_xor_b32 v28, s24, v16
    v_xor_b32 v29, s24, v17
    v_xor_b32 v30, s24, v18
    v_xor_b32 v31, s24, v19
    v_xor_b32 v24, s25, v20
    v_xor_b32 v25, s25, v21
    v_xor_b32 v26, s25, v22
    v_xor_b32 v27, s25, v23
L_tab:
    v_lshlrev_b32 v8, 3, v2
    v_and_b32 v9, 64, v0
    v_lshl_add_u32 v8, v9, 5, v8
    v_lshlrev_b32 v9, 3, v0
    v_and_b32 v7, 0x63, v3
    v_bfe_u32 v11, v3, 2, 2
    v_lshl_add_u32 v7, v11, 3, v7
    v_bfe_u32 v11, v3, 4, 1
    v_lshl_add_u32 v7, v11, 2, v7
    v_and_b32 v11, 3, v0
    v_lshl_add_u32 v7, v11, 7, v7
    v_lshlrev_b32 v7, 1, v7
    v_and_b32 v3, 3, v4
    v_lshlrev_b32 v3, 6, v3
    v_lshl_add_u32 v3, v5, 4, v3
    v_xor_b32 v10, s18, v4
    v_lshlrev_b32 v10, 7, v10
    v_lshl_add_u32 v10, v6, 14, v10
    v_lshl_add_u32 v10, v5, 4, v10
    v_lshlrev_b32 v1, 7, v6
    s_lshr_b32 s26, s17, 1
    s_lshl_b32 s26, s26, 11
    s_and_b32 s27, s17, 1
    s_lshl_b32 s27, s27, 6
    s_add_u32 s26, s26, s27
    s_add_u32 s26, s26, 2097152
    s_lshl_b32 s27, s18, 3
    s_add_u32 s27, s27, 3145728
    s_and_b32 s44, s23, 0x80000000
    s_or_b32 s44, s44, 1.0
    s_and_b32 s45, s24, 0x80000000
    s_or_b32 s45, s45, 1.0
    s_bitcmp1_b32 s16, 0
    s_cselect_b32 s42, 0, s45
    s_cselect_b32 s43, s45, 0
    s_mov_b32 s38, 0xffff0000
    s_lshr_b32 s61, s2, 4
    s_lshl2_add_u32 s61, s61, s16
    s_cmp_eq_u32 s61, 63
    s_cselect_b64 s[62:63], 0xff, 0
    s_and_b32 s61, s2, 15
    s_lshl_b32 s61, s61, 2
    s_add_u32 s61, s61, 3162112
    v_lshlrev_b32 v95, 11, v2
    v_lshlrev_b32 v11, 2, v5
    s_cmp_eq_u32 s2, 256
    s_cbranch_scc1 L_p2x
    s_waitcnt vmcnt(4)
    v_add_u32 v101, 0x11111111, v15
    s_cmp_eq_u32 s17, 0
    s_waitcnt vmcnt(3)
    v_lshlrev_b32 v76, 16, v64
    v_and_b32 v77, s38, v64
    v_lshlrev_b32 v78, 16, v65
    v_and_b32 v79, s38, v65
    s_waitcnt vmcnt(2)
    s_cbranch_scc0 L_nofix0
    v_cndmask_b32 v68, v68, v69, s[30:31]
    v_cndmask_b32 v69, v69, v70, s[30:31]
    v_cndmask_b32 v70, v70, 0, s[30:31]
L_nofix0:
    v_lshlrev_b32 v84, 16, v70
    v_and_b32 v85, s38, v69
    v_lshlrev_b32 v86, 16, v69
    v_and_b32 v87, s38, v68
    v_pk_add_f32 v[76:77], v[76:77], v[84:85]
    v_pk_add_f32 v[78:79], v[78:79], v[86:87]
    ds_write_b16 v7, v68 offset:28672
    s_waitcnt vmcnt(1)
    v_lshlrev_b32 v80, 16, v66
    v_and_b32 v81, s38, v66
    v_lshlrev_b32 v82, 16, v67
    v_and_b32 v83, s38, v67
    s_waitcnt vmcnt(0)
    s_mov_b64 exec, s[62:63]
    buffer_store_dword v101, v95, s[12:15], s61 offen sc1
    s_mov_b64 exec, -1
    s_cbranch_scc0 L_nofix1
    v_cndmask_b32 v72, v72, v73, s[30:31]
    v_cndmask_b32 v73, v73, v74, s[30:31]
    v_cndmask_b32 v74, v74, 0, s[30:31]
L_nofix1:
    v_lshlrev_b32 v88, 16, v74
    v_and_b32 v89, s38, v73
    v_lshlrev_b32 v90, 16, v73
    v_and_b32 v91, s38, v72
    v_pk_add_f32 v[80:81], v[80:81], v[88:89]
    v_pk_add_f32 v[82:83], v[82:83], v[90:91]
    ds_write_b16 v7, v72 offset:28800
    v_pk_add_f32 v[84:85], v[76:77], v[80:81]
    v_pk_add_f32 v[86:87], v[78:79], v[82:83]
    v_pk_add_f32 v[88:89], v[76:77], v[80:81] neg_lo:[0,1] neg_hi:[0,1]
    v_pk_add_f32 v[90:91], v[78:79], v[82:83] neg_lo:[0,1] neg_hi:[0,1]
    v_cvt_pk_bf16_f32 v64, v84, v85
    v_cvt_pk_bf16_f32 v65, v86, v87
    v_cvt_pk_bf16_f32 v66, v88, v89
    v_cvt_pk_bf16_f32 v67, v90, v91
    ds_write2st64_b64 v9, v[64:65], v[66:67] offset0:48 offset1:52
    s_waitcnt lgkmcnt(0)
    s_barrier
    ds_read_b64_tr_b16 v[64:65], v8 offset:24576
    ds_read_b64_tr_b16 v[66:67], v8 offset:25088
    ds_read_b64_tr_b16 v[68:69], v8 offset:25600
    ds_read_b64_tr_b16 v[70:71], v8 offset:26112
    ds_read_b128 v[80:83], v3 offset:29440
    v_lshrrev_b32 v12, v11, v101
    v_lshrrev_b32 v13, 1, v12
    v_lshrrev_b32 v14, 2, v12
    v_lshrrev_b32 v15, 3, v12
    v_readfirstlane_b32 s36, v101
    s_waitcnt lgkmcnt(3)
    v_mfma_f32_16x16x32_bf16 v[48:51], v[64:67], v[16:19], 0
    v_mfma_f32_16x16x32_bf16 v[52:55], v[64:67], v[20:23], 0
    s_waitcnt lgkmcnt(1)
    v_mfma_f32_16x16x32_bf16 v[48:51], v[68:71], v[24:27], v[48:51]
    v_mfma_f32_16x16x32_bf16 v[52:55], v[68:71], v[28:31], v[52:55]
    s_waitcnt lgkmcnt(0)
    v_mfma_f32_16x16x32_bf16 v[56:59], v[80:83], v[16:19], 0
    v_mfma_f32_16x16x32_bf16 v[60:63], v[80:83], v[20:23], 0
    s_cmp_eq_u32 s17, 15
    s_nop 2
    v_cvt_pk_bf16_f32 v96, v48, v49
    v_cvt_pk_bf16_f32 v97, v50, v51
    v_cvt_pk_bf16_f32 v98, v52, v53
    v_cvt_pk_bf16_f32 v99, v54, v55
    v_bfi_b32 v96, s37, v12, v96
    v_bfi_b32 v97, s37, v13, v97
    v_bfi_b32 v98, s37, v14, v98
    v_bfi_b32 v99, s37, v15, v99
    buffer_store_dwordx4 v[96:99], v10, s[12:15], s26 offen sc1
    s_cbranch_scc0 L_p2
    v_fmac_f32 v56, s44, v58
    v_fmac_f32 v57, s44, v59
    v_fmac_f32 v60, s44, v62
    v_fmac_f32 v61, s44, v63
    v_fmac_f32 v56, s42, v57
    v_fmac_f32 v60, s43, v57
    v_fma_f32 v56, -s43, v61, v56
    v_fmac_f32 v60, s42, v61
    s_mov_b64 exec, 0xffff
    v_cvt_pk_bf16_f32 v100, v56, v60
    buffer_store_dwordx2 v[100:101], v1, s[12:15], s27 offen sc1
    s_mov_b64 exec, -1
    s_branch L_p2
L_p2x:
    s_waitcnt vmcnt(0)
    v_add_u32 v101, 0x11111111, v15
    s_nop 0
    v_readfirstlane_b32 s36, v101
L_p2:
    s_mov_b32 s34, 0x200000
    s_mov_b32 s35, 0x20000
    s_mov_b32 s39, 0
    s_and_b32 s48, s2, 7
    s_bfe_u32 s49, s2, 0x30005
    s_lshl_b32 s49, s49, 3
    s_or_b32 s48, s48, s49
    s_bfe_u32 s49, s2, 0x20003
    s_lshl_b32 s50, s48, 14
    s_lshl_b32 s51, s16, 12
    s_add_u32 s50, s50, s51
    s_add_u32 s50, s50, 2096128
    s_mov_b32 m0, s51
    v_bfe_u32 v119, v2, 2, 3
    v_lshlrev_b32 v119, 7, v119
    v_lshrrev_b32 v122, 5, v2
    v_lshl_add_u32 v119, v122, 6, v119
    v_and_b32 v122, 3, v2
    v_lshl_add_u32 v119, v122, 4, v119
    s_lshr_b32 s52, s48, 2
    s_lshl_b32 s52, s52, 7
    v_xor_b32 v119, s52, v119
    v_xor_b32 v117, 0x400, v119
    v_add_u32 v119, 0x400, v119
    s_lshl_b32 s52, s48, 7
    s_add_u32 s52, s52, 3145728
    v_lshlrev_b32 v92, 4, v5
    s_lshl_b32 s54, s49, 9
    s_add_u32 s54, s54, s48
    s_and_b32 s55, s49, 1
    s_lshl_b32 s55, s55, 9
    s_lshr_b32 s56, s49, 1
    s_lshl_b32 s57, s56, 6
    s_add_u32 s55, s55, s57
    s_lshr_b32 s57, s2, 8
    s_lshl_b32 s57, s57, 10
    s_add_u32 s55, s55, s57
    s_lshl_b32 s56, s56, 4
    s_cmp_eq_u32 s48, 0
    s_cselect_b32 s54, s55, s54
    s_cselect_b32 s55, 0xffff, -1
    s_cselect_b32 s56, s56, 0
    v_lshrrev_b32 v122, 2, v4
    v_lshl_add_u32 v122, v122, 7, s54
    v_cvt_f32_u32 v122, v122
    v_mul_f32 v122, 0x3a000000, v122
    v_and_b32 v123, 1, v2
    v_cvt_f32_u32 v123, v123
    v_mul_f32 v123, 0xbe800000, v123
    v_cvt_f32_u32 v124, v5
    v_add_f32 v125, v124, v124
    v_fma_f32 v128, v122, v125, v123
    v_cos_f32 v129, v128
    v_sin_f32 v130, -v128
    s_nop 0
    v_cvt_pk_bf16_f32 v132, v129, v130
    v_and_b32 v132, s55, v132
    v_lshlrev_b32 v132, s56, v132
    v_add_f32 v127, 0x3f800000, v125
    v_fma_f32 v128, v122, v127, v123
    v_cos_f32 v129, v128
    v_sin_f32 v130, -v128
    s_nop 0
    v_cvt_pk_bf16_f32 v133, v129, v130
    v_and_b32 v133, s55, v133
    v_lshlrev_b32 v133, s56, v133
    v_add_f32 v127, 0x41000000, v125
    v_fma_f32 v128, v122, v127, v123
    v_cos_f32 v129, v128
    v_sin_f32 v130, -v128
    s_nop 0
    v_cvt_pk_bf16_f32 v134, v129, v130
    v_and_b32 v134, s55, v134
    v_lshlrev_b32 v134, s56, v134
    v_add_f32 v127, 0x41100000, v125
    v_fma_f32 v128, v122, v127, v123
    v_cos_f32 v129, v128
    v_sin_f32 v130, -v128
    s_nop 0
    v_cvt_pk_bf16_f32 v135, v129, v130
    v_and_b32 v135, s55, v135
    v_lshlrev_b32 v135, s56, v135
    s_add_u32 s53, s51, 32768
    s_lshl_b32 s47, s16, 4
    s_and_b32 s61, s2, 7
    s_lshl_b32 s61, s61, 11
    s_add_u32 s61, s61, 3162112
    v_lshlrev_b32 v95, 2, v4
    v_cvt_f32_u32 v122, v4
    v_mul_f32 v125, 4.0, v124
    v_mul_f32 v123, 0x3d800000, v122
    v_add_f32 v131, 0x3d000000, v123
    v_mul_f32 v128, v123, v125
    v_cos_f32 v129, v128
    v_sin_f32 v130, v128
    v_mul_f32 v128, 0x3d800000, v128
    v_cvt_pk_bf16_f32 v140, v129, -v130
    v_cvt_pk_bf16_f32 v144, v130, v129
    v_cos_f32 v156, v128
    v_sin_f32 v160, v128
    v_mul_f32 v128, v131, v125
    v_cos_f32 v129, v128
    v_sin_f32 v130, v128
    v_mul_f32 v128, 0x3d800000, v128
    v_cvt_pk_bf16_f32 v148, v129, -v130
    v_cvt_pk_bf16_f32 v152, v130, v129
    v_cos_f32 v164, v128
    v_sin_f32 v168, v128
    v_add_f32 v127, 0x3f800000, v125
    v_mul_f32 v128, v123, v127
    v_cos_f32 v129, v128
    v_sin_f32 v130, v128
    v_mul_f32 v128, 0x3d800000, v128
    v_cvt_pk_bf16_f32 v141, v129, -v130
    v_cvt_pk_bf16_f32 v145, v130, v129
    v_cos_f32 v157, v128
    v_sin_f32 v161, v128
    v_mul_f32 v128, v131, v127
    v_cos_f32 v129, v128
    v_sin_f32 v130, v128
    v_mul_f32 v128, 0x3d800000, v128
    v_cvt_pk_bf16_f32 v149, v129, -v130
    v_cvt_pk_bf16_f32 v153, v130, v129
    v_cos_f32 v165, v128
    v_sin_f32 v169, v128
    v_add_f32 v127, 0x40000000, v125
    v_mul_f32 v128, v123, v127
    v_cos_f32 v129, v128
    v_sin_f32 v130, v128
    v_mul_f32 v128, 0x3d800000, v128
    v_cvt_pk_bf16_f32 v142, v129, -v130
    v_cvt_pk_bf16_f32 v146, v130, v129
    v_cos_f32 v158, v128
    v_sin_f32 v162, v128
    v_mul_f32 v128, v131, v127
    v_cos_f32 v129, v128
    v_sin_f32 v130, v128
    v_mul_f32 v128, 0x3d800000, v128
    v_cvt_pk_bf16_f32 v150, v129, -v130
    v_cvt_pk_bf16_f32 v154, v130, v129
    v_cos_f32 v166, v128
    v_sin_f32 v170, v128
    v_add_f32 v127, 0x40400000, v125
    v_mul_f32 v128, v123, v127
    v_cos_f32 v129, v128
    buffer_load_dword v112, v95, s[12:15], s61 offen sc1
    v_sin_f32 v130, v128
    v_mul_f32 v128, 0x3d800000, v128
    v_cvt_pk_bf16_f32 v143, v129, -v130
    v_cvt_pk_bf16_f32 v147, v130, v129
    v_cos_f32 v159, v128
    v_sin_f32 v163, v128
    v_mul_f32 v128, v131, v127
    v_cos_f32 v129, v128
    v_sin_f32 v130, v128
    v_mul_f32 v128, 0x3d800000, v128
    v_cvt_pk_bf16_f32 v151, v129, -v130
    v_cvt_pk_bf16_f32 v155, v130, v129
    v_cos_f32 v167, v128
    v_sin_f32 v171, v128
    v_lshrrev_b32 v122, 3, v2
    v_lshlrev_b32 v122, 6, v122
    v_and_b32 v123, 3, v2
    v_lshl_add_u32 v122, v123, 4, v122
    v_and_b32 v123, 4, v2
    v_lshl_add_u32 v122, v123, 1, v122
    v_add_u32 v122, s51, v122
    v_lshlrev_b32 v123, 11, v5
    v_lshl_add_u32 v123, v4, 4, v123
    s_lshl_b32 s57, s16, 8
    v_add_u32 v123, s57, v123
    s_lshl_b32 s57, s16, 11
    v_lshl_add_u32 v124, v2, 4, s57
    v_lshl_add_u32 v125, v4, 2, v5
    v_add_u32 v127, 1, v125
    v_lshlrev_b32 v125, 4, v125
    v_sub_u32 v126, 1008, v125
    v_and_b32 v128, 3, v127
    v_and_b32 v127, 60, v127
    v_lshl_add_u32 v127, v128, 6, v127
    s_lshl_b32 s57, s16, 7
    s_add_u32 s57, s57, s54
    s_sub_u32 s58, 2048, s57
    s_lshl_b32 s58, s58, 10
    s_and_b32 s60, s57, 1023
    s_cmp_eq_u32 s2, 256
    s_cselect_b32 s59, s16, 0
    s_lshl_b32 s57, s57, 10
    v_and_b32 v128, 12, v4
    v_bfe_u32 v129, v4, 1, 1
    v_add_u32 v128, v128, v129
    v_and_b32 v129, 1, v4
    v_lshl_add_u32 v128, v129, 4, v128
    v_lshrrev_b32 v128, v128, s36
    v_lshlrev_b32 v129, 14, v128
    v_bfi_b32 v113, 1, v128, v129
L_hint:
    s_waitcnt vmcnt(0)
    v_cmp_ne_u32 vcc, s36, v112
    s_cbranch_vccz L_hok
    buffer_load_dword v112, v95, s[12:15], s61 offen sc1
    s_add_u32 s39, s39, 1
    s_cmp_lt_u32 s39, 50000
    s_cbranch_scc1 L_hint
L_hok:
    s_waitcnt vmcnt(0)
    s_mov_b32 m0, s51
    s_add_u32 s39, s39, 1
    buffer_load_dwordx4 v119, s[12:15], s50 offen offset:0 sc1 lds
    buffer_load_dwordx4 v117, s[12:15], s50 offen offset:1024 sc1 lds
    buffer_load_dwordx4 v119, s[12:15], s50 offen offset:2048 sc1 lds
    buffer_load_dwordx4 v117, s[12:15], s50 offen offset:3072 sc1 lds
    buffer_load_dwordx4 v[56:59], v92, s[12:15], s52 offen offset:0 sc1
    buffer_load_dwordx4 v[60:63], v92, s[12:15], s52 offen offset:64 sc1
L_round:
    s_waitcnt vmcnt(4)
    ds_read_b64_tr_b16 v[64:65], v122 offset:0
    ds_read_b64_tr_b16 v[66:67], v122 offset:1024
    ds_read_b64_tr_b16 v[68:69], v122 offset:512
    ds_read_b64_tr_b16 v[70:71], v122 offset:1536
    s_waitcnt vmcnt(2)
    ds_read_b64_tr_b16 v[72:73], v122 offset:2048
    ds_read_b64_tr_b16 v[74:75], v122 offset:3072
    ds_read_b64_tr_b16 v[76:77], v122 offset:2560
    ds_read_b64_tr_b16 v[78:79], v122 offset:3584
    s_waitcnt vmcnt(0)
    v_mov_b32 v88, v56
    v_mov_b32 v89, v58
    v_mov_b32 v90, v60
    v_mov_b32 v91, v62
    v_bitop3_b32 v93, v57, v59, s36 bitop3:0x7e
    v_bitop3_b32 v94, v61, v63, s36 bitop3:0x7e
    v_mfma_f32_16x16x32_bf16 v[84:87], v[132:135], v[88:91], 0
    s_waitcnt lgkmcnt(6)
    v_mfma_f32_16x16x32_bf16 v[96:99], v[132:135], v[64:67], 0
    v_bitop3_b32 v114, v64, v65, v113 bitop3:0x7e
    v_bitop3_b32 v115, v66, v67, v113 bitop3:0x7e
    v_or_b32 v112, v114, v115
    s_waitcnt lgkmcnt(4)
    v_mfma_f32_16x16x32_bf16 v[100:103], v[132:135], v[68:71], 0
    v_bitop3_b32 v114, v68, v69, v113 bitop3:0x7e
    v_bitop3_b32 v115, v70, v71, v113 bitop3:0x7e
    v_or3_b32 v112, v112, v114, v115
    s_waitcnt lgkmcnt(2)
    v_mfma_f32_16x16x32_bf16 v[104:107], v[132:135], v[72:75], 0
    v_bitop3_b32 v114, v72, v73, v113 bitop3:0x7e
    v_bitop3_b32 v115, v74, v75, v113 bitop3:0x7e
    v_or3_b32 v112, v112, v114, v115
    s_waitcnt lgkmcnt(0)
    v_mfma_f32_16x16x32_bf16 v[108:111], v[132:135], v[76:79], 0
    v_bitop3_b32 v114, v76, v77, v113 bitop3:0x7e
    v_bitop3_b32 v115, v78, v79, v113 bitop3:0x7e
    v_or3_b32 v112, v112, v114, v115
    v_and_b32 v112, s37, v112
    v_or3_b32 v112, v112, v93, v94
    v_cmp_ne_u32 vcc, 0, v112
    s_cbranch_vccz L_go
    s_mov_b32 m0, s51
    s_add_u32 s39, s39, 1
    buffer_load_dwordx4 v119, s[12:15], s50 offen offset:0 sc1 lds
    buffer_load_dwordx4 v117, s[12:15], s50 offen offset:1024 sc1 lds
    buffer_load_dwordx4 v119, s[12:15], s50 offen offset:2048 sc1 lds
    buffer_load_dwordx4 v117, s[12:15], s50 offen offset:3072 sc1 lds
    buffer_load_dwordx4 v[56:59], v92, s[12:15], s52 offen offset:0 sc1
    buffer_load_dwordx4 v[60:63], v92, s[12:15], s52 offen offset:64 sc1
    s_cmp_lt_u32 s39, 100000
    s_cbranch_scc1 L_round
L_go:
    v_cvt_pk_bf16_f32 v64, v96, v97
    v_cvt_pk_bf16_f32 v65, v100, v101
    v_cvt_pk_bf16_f32 v66, v104, v105
    v_cvt_pk_bf16_f32 v67, v108, v109
    ds_write_b128 v123, v[64:67] offset:16384
    v_readlane_b32 s46, v84, s47
    s_waitcnt lgkmcnt(0)
    s_barrier
    s_cmp_lg_u32 s59, 0
    s_cbranch_scc1 L_extra
    ds_read_b128 v[72:75], v124 offset:16384
    v_mov_b32 v104, s46
    v_mov_b32 v105, s46
    v_mov_b32 v106, s46
    v_mov_b32 v107, s46
    v_sub_f32 v108, 0, v104
    v_sub_f32 v109, 0, v104
    v_sub_f32 v110, 0, v104
    v_sub_f32 v111, 0, v104
    s_waitcnt lgkmcnt(0)
    v_mfma_f32_16x16x32_bf16 v[80:83], v[72:75], v[140:143], 0
    v_mfma_f32_16x16x32_bf16 v[84:87], v[72:75], v[144:147], 0
    v_mfma_f32_16x16x32_bf16 v[88:91], v[72:75], v[148:151], 0
    v_mfma_f32_16x16x32_bf16 v[92:95], v[72:75], v[152:155], 0
    s_nop 4
    v_pk_mul_f32 v[96:97], v[80:81], v[156:157]
    v_pk_mul_f32 v[100:101], v[80:81], v[160:161]
    v_pk_mul_f32 v[98:99], v[82:83], v[158:159]
    v_pk_mul_f32 v[102:103], v[82:83], v[162:163]
    v_pk_fma_f32 v[96:97], v[84:85], v[160:161], v[96:97] neg_lo:[1,0,0] neg_hi:[1,0,0]
    v_pk_fma_f32 v[100:101], v[84:85], v[156:157], v[100:101]
    v_pk_fma_f32 v[98:99], v[86:87], v[162:163], v[98:99] neg_lo:[1,0,0] neg_hi:[1,0,0]
    v_pk_fma_f32 v[102:103], v[86:87], v[158:159], v[102:103]
    v_cvt_pk_bf16_f32 v64, v96, v100
    v_cvt_pk_bf16_f32 v65, v97, v101
    v_cvt_pk_bf16_f32 v66, v98, v102
    v_cvt_pk_bf16_f32 v67, v99, v103
    s_nop 1
    v_mfma_f32_16x16x32_bf16 v[104:107], v[64:67], v[140:143], v[104:107]
    v_pk_mul_f32 v[96:97], v[88:89], v[164:165]
    v_pk_mul_f32 v[100:101], v[88:89], v[168:169]
    v_pk_mul_f32 v[98:99], v[90:91], v[166:167]
    v_pk_mul_f32 v[102:103], v[90:91], v[170:171]
    v_pk_fma_f32 v[96:97], v[92:93], v[168:169], v[96:97] neg_lo:[1,0,0] neg_hi:[1,0,0]
    v_pk_fma_f32 v[100:101], v[92:93], v[164:165], v[100:101]
    v_pk_fma_f32 v[98:99], v[94:95], v[170:171], v[98:99] neg_lo:[1,0,0] neg_hi:[1,0,0]
    v_pk_fma_f32 v[102:103], v[94:95], v[166:167], v[102:103]
    ds_bpermute_b32 v72, v127, v104
    v_cvt_pk_bf16_f32 v68, v96, v100
    v_cvt_pk_bf16_f32 v69, v97, v101
    v_cvt_pk_bf16_f32 v70, v98, v102
    v_cvt_pk_bf16_f32 v71, v99, v103
    s_nop 1
    v_mfma_f32_16x16x32_bf16 v[108:111], v[68:71], v[140:143], v[108:111]
    s_cmp_eq_u32 s60, 0
    s_waitcnt vmcnt(0) lgkmcnt(0)
    s_nop 5
    v_cvt_pk_bf16_f32 v64, v104, v108
    v_cvt_pk_bf16_f32 v65, v105, v109
    v_cvt_pk_bf16_f32 v66, v106, v110
    v_cvt_pk_bf16_f32 v67, v107, v111
    buffer_store_dwordx4 v[64:67], v125, s[32:35], s57 offen
    s_cbranch_scc1 L_end
    v_cvt_pk_bf16_f32 v69, v107, v110
    v_cvt_pk_bf16_f32 v70, v106, v109
    v_cvt_pk_bf16_f32 v71, v105, v108
    v_cvt_pk_bf16_f32 v68, v72, v111
    buffer_store_dwordx4 v[68:71], v126, s[32:35], s58 offen
    s_endpgm
L_extra:
    s_waitcnt vmcnt(0)
    v_mov_b32 v117, s36
    s_mov_b64 exec, 1
    buffer_store_dword v117, off, s[12:15], 0
L_end:
    s_endpgm
.section .rodata,"a"
.p2align 6
.amdhsa_kernel standalone__spectral_fnet__prompt_kernel
  .amdhsa_next_free_vgpr 172
  .amdhsa_next_free_sgpr 64
  .amdhsa_accum_offset 172
  .amdhsa_group_segment_fixed_size 0
  .amdhsa_kernarg_size 64
  .amdhsa_user_sgpr_count 2
  .amdhsa_user_sgpr_kernarg_segment_ptr 1
  .amdhsa_system_sgpr_workgroup_id_x 1
.end_amdhsa_kernel
```
